```python
import torch

def _softmax(x, axis=-1):
    return torch.softmax(x, dim=axis)
def _gelu(x):
    return torch.nn.functional.gelu(x, approximate="tanh")
def _silu(x):
    return torch.nn.functional.silu(x)
def _sigmoid(x):
    return torch.sigmoid(x)
def _layernorm(x, axis=-1, eps=1e-5):
    m = x.mean(dim=axis, keepdim=True)
    v = x.var(dim=axis, keepdim=True, unbiased=False)
    return (x - m) / torch.sqrt(v + eps)
def _scatter_add(tgt, idx, src, axis=0):
    return tgt.clone().index_add_(axis, idx, src)
def _segment_sum(src, seg, n):
    out = torch.zeros((n,) + src.shape[1:], dtype=src.dtype)
    return out.index_add_(0, seg, src)
def _pad(x, pw):
    flat = tuple(v for pair in reversed(pw) for v in pair)
    return torch.nn.functional.pad(x, flat)

kernel_name = 'gather_scatter__edge_featured_mpnn_mpnn__graph'

def setup_inputs():

    _w = (lambda a: (lambda t: t.to(torch.bfloat16) if t.is_floating_point() else t)(torch.as_tensor(a)))
    N, deg, D, De = 10000, 32, 128, max(0, 1)
    E = N * deg
    H = 2 * D
    return {
        "x": _w((lambda *s: torch.randn(*s, dtype=torch.bfloat16) * 0.05)(N, D)),
        "e_attr": _w((lambda *s: torch.randn(*s, dtype=torch.bfloat16) * 1.6)(E, De)),
        "src": _w((lambda lo, hi, *s: torch.randint(lo, hi, s))(0, N, E).to(torch.int64)),
        "dst": _w((lambda lo, hi, *s: torch.randint(lo, hi, s))(0, N, E).to(torch.int64)),
        "w1": _w((lambda *s: torch.randn(*s, dtype=torch.bfloat16) * 1.6)(2 * D + De, H) * (1.0 / (2 * D + De) ** 0.5)),
        "b1": _w((lambda *s: torch.randn(*s, dtype=torch.bfloat16) * 0.8)(H) * 0.01),
        "w2": _w((lambda *s: torch.randn(*s, dtype=torch.bfloat16) * 0.05)(H, D) * (1.0 / H ** 0.5)),
        "b2": _w((lambda *s: torch.randn(*s, dtype=torch.bfloat16) * 0.05)(D) * 0.01),
    }

def reference(x, e_attr, src, dst, w1, b1, w2, b2):
    N, D = x.shape
    h_src = x[src]
    h_dst = x[dst]
    m_in = torch.concatenate([h_src, h_dst, e_attr], axis=-1)
    h = _silu(m_in @ w1 + b1)
    msg = h @ w2 + b2
    return _segment_sum(msg, dst, N)
```

```asm
; @launch kernel=prep_kernel grid=(409,1,1) block=(512,1,1) lds=6144
; @launch kernel=main_kernel grid=(1250,1,1) block=(256,1,1) lds=27136
.amdgcn_target "amdgcn-amd-amdhsa--gfx950"
.text
.globl prep_kernel
.p2align 8
.type prep_kernel,@function
prep_kernel:
    s_load_dwordx4 s[4:7], s[0:1], 0
    s_load_dwordx4 s[8:11], s[0:1], 16
    s_load_dwordx4 s[12:15], s[0:1], 32
    s_load_dwordx4 s[16:19], s[0:1], 48
    s_load_dwordx2 s[20:21], s[0:1], 80
    s_waitcnt lgkmcnt(0)
    s_cmp_ge_u32 s2, 409
    s_cbranch_scc1 L_prep_end
    s_cmp_ge_u32 s2, 377
    s_cbranch_scc1 L_w2t
    s_cmp_ge_u32 s2, 64
    s_cbranch_scc1 L_gemm
    s_mov_b32 s24, s8
    s_mov_b32 s25, s9
    s_mov_b32 s26, 1280000
    s_mov_b32 s27, 0x00020000
    s_mov_b32 s28, s10
    s_mov_b32 s29, s11
    s_mov_b32 s30, 1280000
    s_mov_b32 s31, 0x00020000
    s_mov_b32 s32, s6
    s_mov_b32 s33, s7
    s_mov_b32 s34, 640000
    s_mov_b32 s35, 0x00020000
    s_add_u32 s36, s20, 33554432
    s_addc_u32 s37, s21, 0
    s_mov_b32 s38, 2560000
    s_mov_b32 s39, 0x00020000
    s_add_u32 s40, s20, 37748736
    s_addc_u32 s41, s21, 0
    s_mov_b32 s42, 327680
    s_mov_b32 s43, 0x00020000
    s_mul_i32 s44, s2, 5000
    v_lshlrev_b32 v1, 2, v0
    v_mov_b32 v2, 0
    ds_write_b32 v1, v2
    ds_write_b32 v1, v2 offset:2048
    ds_write_b32 v1, v2 offset:4096
    v_add_u32 v3, s44, v0
    v_lshlrev_b32 v4, 2, v3
    v_lshlrev_b32 v5, 1, v3
    v_cmp_gt_u32 vcc, 392, v0
    s_mov_b64 s[46:47], vcc
    buffer_load_dword v10, v4, s[28:31], 0 offen offset:0
    buffer_load_dword v20, v4, s[24:27], 0 offen offset:0
    buffer_load_ushort v30, v5, s[32:35], 0 offen offset:0
    buffer_load_dword v11, v4, s[28:31], 0 offen offset:2048
    buffer_load_dword v21, v4, s[24:27], 0 offen offset:2048
    buffer_load_ushort v31, v5, s[32:35], 0 offen offset:1024
    s_mov_b32 s45, 4096
    buffer_load_dword v12, v4, s[28:31], s45 offen
    buffer_load_dword v22, v4, s[24:27], s45 offen
    buffer_load_ushort v32, v5, s[32:35], 0 offen offset:2048
    s_mov_b32 s45, 6144
    buffer_load_dword v13, v4, s[28:31], s45 offen
    buffer_load_dword v23, v4, s[24:27], s45 offen
    buffer_load_ushort v33, v5, s[32:35], 0 offen offset:3072
    s_mov_b32 s45, 8192
    buffer_load_dword v14, v4, s[28:31], s45 offen
    buffer_load_dword v24, v4, s[24:27], s45 offen
    s_mov_b32 s48, 4096
    buffer_load_ushort v34, v5, s[32:35], s48 offen
    s_mov_b32 s45, 10240
    buffer_load_dword v15, v4, s[28:31], s45 offen
    buffer_load_dword v25, v4, s[24:27], s45 offen
    s_mov_b32 s48, 5120
    buffer_load_ushort v35, v5, s[32:35], s48 offen
    s_mov_b32 s45, 12288
    buffer_load_dword v16, v4, s[28:31], s45 offen
    buffer_load_dword v26, v4, s[24:27], s45 offen
    s_mov_b32 s48, 6144
    buffer_load_ushort v36, v5, s[32:35], s48 offen
    s_mov_b32 s45, 14336
    buffer_load_dword v17, v4, s[28:31], s45 offen
    buffer_load_dword v27, v4, s[24:27], s45 offen
    s_mov_b32 s48, 7168
    buffer_load_ushort v37, v5, s[32:35], s48 offen
    s_mov_b32 s45, 16384
    buffer_load_dword v18, v4, s[28:31], s45 offen
    buffer_load_dword v28, v4, s[24:27], s45 offen
    s_mov_b32 s48, 8192
    buffer_load_ushort v38, v5, s[32:35], s48 offen
    s_mov_b64 s[50:51], exec
    s_mov_b64 exec, s[46:47]
    s_mov_b32 s45, 18432
    s_mov_b32 s48, 9216
    buffer_load_dword v19, v4, s[28:31], s45 offen
    buffer_load_dword v29, v4, s[24:27], s45 offen
    buffer_load_ushort v39, v5, s[32:35], s48 offen
    s_mov_b64 exec, s[50:51]
    s_waitcnt lgkmcnt(0)
    s_barrier
    v_mov_b32 v2, 1
    s_waitcnt vmcnt(29)
    v_lshrrev_b32 v6, 3, v10
    v_lshlrev_b32 v6, 2, v6
    ds_add_rtn_u32 v40, v6, v2
    s_waitcnt vmcnt(26)
    v_lshrrev_b32 v6, 3, v11
    v_lshlrev_b32 v6, 2, v6
    ds_add_rtn_u32 v41, v6, v2
    s_waitcnt vmcnt(23)
    v_lshrrev_b32 v6, 3, v12
    v_lshlrev_b32 v6, 2, v6
    ds_add_rtn_u32 v42, v6, v2
    s_waitcnt vmcnt(20)
    v_lshrrev_b32 v6, 3, v13
    v_lshlrev_b32 v6, 2, v6
    ds_add_rtn_u32 v43, v6, v2
    s_waitcnt vmcnt(17)
    v_lshrrev_b32 v6, 3, v14
    v_lshlrev_b32 v6, 2, v6
    ds_add_rtn_u32 v44, v6, v2
    s_waitcnt vmcnt(14)
    v_lshrrev_b32 v6, 3, v15
    v_lshlrev_b32 v6, 2, v6
    ds_add_rtn_u32 v45, v6, v2
    s_waitcnt vmcnt(11)
    v_lshrrev_b32 v6, 3, v16
    v_lshlrev_b32 v6, 2, v6
    ds_add_rtn_u32 v46, v6, v2
    s_waitcnt vmcnt(8)
    v_lshrrev_b32 v6, 3, v17
    v_lshlrev_b32 v6, 2, v6
    ds_add_rtn_u32 v47, v6, v2
    s_waitcnt vmcnt(5)
    v_lshrrev_b32 v6, 3, v18
    v_lshlrev_b32 v6, 2, v6
    ds_add_rtn_u32 v48, v6, v2
    s_mov_b64 exec, s[46:47]
    s_waitcnt vmcnt(0)
    v_lshrrev_b32 v6, 3, v19
    v_lshlrev_b32 v6, 2, v6
    ds_add_rtn_u32 v49, v6, v2
    s_mov_b64 exec, s[50:51]
    s_waitcnt lgkmcnt(0)
    s_barrier
    v_cmp_gt_u32 vcc, 64, v0
    s_and_saveexec_b64 s[52:53], vcc
    s_cbranch_execz L_scan_done
    v_mul_u32_u24 v6, 80, v0
    ds_read_b128 v[60:63], v6 offset:0
    ds_read_b128 v[64:67], v6 offset:16
    ds_read_b128 v[68:71], v6 offset:32
    ds_read_b128 v[72:75], v6 offset:48
    ds_read_b128 v[76:79], v6 offset:64
    s_waitcnt lgkmcnt(0)
    v_mov_b32 v7, 0
    v_mov_b32 v80, v7
    v_add_u32 v7, v7, v60
    v_mov_b32 v81, v7
    v_add_u32 v7, v7, v61
    v_mov_b32 v82, v7
    v_add_u32 v7, v7, v62
    v_mov_b32 v83, v7
    v_add_u32 v7, v7, v63
    v_mov_b32 v84, v7
    v_add_u32 v7, v7, v64
    v_mov_b32 v85, v7
    v_add_u32 v7, v7, v65
    v_mov_b32 v86, v7
    v_add_u32 v7, v7, v66
    v_mov_b32 v87, v7
    v_add_u32 v7, v7, v67
    v_mov_b32 v88, v7
    v_add_u32 v7, v7, v68
    v_mov_b32 v89, v7
    v_add_u32 v7, v7, v69
    v_mov_b32 v90, v7
    v_add_u32 v7, v7, v70
    v_mov_b32 v91, v7
    v_add_u32 v7, v7, v71
    v_mov_b32 v92, v7
    v_add_u32 v7, v7, v72
    v_mov_b32 v93, v7
    v_add_u32 v7, v7, v73
    v_mov_b32 v94, v7
    v_add_u32 v7, v7, v74
    v_mov_b32 v95, v7
    v_add_u32 v7, v7, v75
    v_mov_b32 v96, v7
    v_add_u32 v7, v7, v76
    v_mov_b32 v97, v7
    v_add_u32 v7, v7, v77
    v_mov_b32 v98, v7
    v_add_u32 v7, v7, v78
    v_mov_b32 v99, v7
    v_add_u32 v7, v7, v79
    v_mov_b32 v8, v7
    s_nop 1
    v_add_u32_dpp v8, v8, v8 row_shr:1 row_mask:0xf bank_mask:0xf bound_ctrl:0
    s_nop 1
    v_add_u32_dpp v8, v8, v8 row_shr:2 row_mask:0xf bank_mask:0xf bound_ctrl:0
    s_nop 1
    v_add_u32_dpp v8, v8, v8 row_shr:4 row_mask:0xf bank_mask:0xf bound_ctrl:0
    s_nop 1
    v_add_u32_dpp v8, v8, v8 row_shr:8 row_mask:0xf bank_mask:0xf bound_ctrl:0
    s_nop 1
    v_add_u32_dpp v8, v8, v8 row_bcast:15 row_mask:0xa bank_mask:0xf
    s_nop 1
    v_add_u32_dpp v8, v8, v8 row_bcast:31 row_mask:0xc bank_mask:0xf
    v_sub_u32 v8, v8, v7
    v_add_u32 v80, v80, v8
    v_add_u32 v81, v81, v8
    v_add_u32 v82, v82, v8
    v_add_u32 v83, v83, v8
    v_add_u32 v84, v84, v8
    v_add_u32 v85, v85, v8
    v_add_u32 v86, v86, v8
    v_add_u32 v87, v87, v8
    v_add_u32 v88, v88, v8
    v_add_u32 v89, v89, v8
    v_add_u32 v90, v90, v8
    v_add_u32 v91, v91, v8
    v_add_u32 v92, v92, v8
    v_add_u32 v93, v93, v8
    v_add_u32 v94, v94, v8
    v_add_u32 v95, v95, v8
    v_add_u32 v96, v96, v8
    v_add_u32 v97, v97, v8
    v_add_u32 v98, v98, v8
    v_add_u32 v99, v99, v8
    s_mul_i32 s45, s2, 5120
    ds_write_b128 v6, v[80:83] offset:0
    buffer_store_dwordx4 v[80:83], v6, s[40:43], s45 offen offset:0
    ds_write_b128 v6, v[84:87] offset:16
    buffer_store_dwordx4 v[84:87], v6, s[40:43], s45 offen offset:16
    ds_write_b128 v6, v[88:91] offset:32
    buffer_store_dwordx4 v[88:91], v6, s[40:43], s45 offen offset:32
    ds_write_b128 v6, v[92:95] offset:48
    buffer_store_dwordx4 v[92:95], v6, s[40:43], s45 offen offset:48
    ds_write_b128 v6, v[96:99] offset:64
    buffer_store_dwordx4 v[96:99], v6, s[40:43], s45 offen offset:64
L_scan_done:
    s_mov_b64 exec, s[52:53]
    s_waitcnt lgkmcnt(0)
    s_barrier
    s_lshl_b32 s45, s44, 3
    v_lshrrev_b32 v6, 3, v10
    v_lshlrev_b32 v6, 2, v6
    ds_read_b32 v7, v6
    v_and_b32 v8, 7, v10
    v_lshlrev_b32 v8, 16, v8
    v_or_b32 v51, v8, v30
    v_mov_b32 v50, v20
    s_waitcnt lgkmcnt(0)
    v_add_u32 v7, v7, v40
    v_lshlrev_b32 v7, 3, v7
    buffer_store_dwordx2 v[50:51], v7, s[36:39], s45 offen
    s_nop 1
    v_lshrrev_b32 v6, 3, v11
    v_lshlrev_b32 v6, 2, v6
    ds_read_b32 v7, v6
    v_and_b32 v8, 7, v11
    v_lshlrev_b32 v8, 16, v8
    v_or_b32 v51, v8, v31
    v_mov_b32 v50, v21
    s_waitcnt lgkmcnt(0)
    v_add_u32 v7, v7, v41
    v_lshlrev_b32 v7, 3, v7
    buffer_store_dwordx2 v[50:51], v7, s[36:39], s45 offen
    s_nop 1
    v_lshrrev_b32 v6, 3, v12
    v_lshlrev_b32 v6, 2, v6
    ds_read_b32 v7, v6
    v_and_b32 v8, 7, v12
    v_lshlrev_b32 v8, 16, v8
    v_or_b32 v51, v8, v32
    v_mov_b32 v50, v22
    s_waitcnt lgkmcnt(0)
    v_add_u32 v7, v7, v42
    v_lshlrev_b32 v7, 3, v7
    buffer_store_dwordx2 v[50:51], v7, s[36:39], s45 offen
    s_nop 1
    v_lshrrev_b32 v6, 3, v13
    v_lshlrev_b32 v6, 2, v6
    ds_read_b32 v7, v6
    v_and_b32 v8, 7, v13
    v_lshlrev_b32 v8, 16, v8
    v_or_b32 v51, v8, v33
    v_mov_b32 v50, v23
    s_waitcnt lgkmcnt(0)
    v_add_u32 v7, v7, v43
    v_lshlrev_b32 v7, 3, v7
    buffer_store_dwordx2 v[50:51], v7, s[36:39], s45 offen
    s_nop 1
    v_lshrrev_b32 v6, 3, v14
    v_lshlrev_b32 v6, 2, v6
    ds_read_b32 v7, v6
    v_and_b32 v8, 7, v14
    v_lshlrev_b32 v8, 16, v8
    v_or_b32 v51, v8, v34
    v_mov_b32 v50, v24
    s_waitcnt lgkmcnt(0)
    v_add_u32 v7, v7, v44
    v_lshlrev_b32 v7, 3, v7
    buffer_store_dwordx2 v[50:51], v7, s[36:39], s45 offen
    s_nop 1
    v_lshrrev_b32 v6, 3, v15
    v_lshlrev_b32 v6, 2, v6
    ds_read_b32 v7, v6
    v_and_b32 v8, 7, v15
    v_lshlrev_b32 v8, 16, v8
    v_or_b32 v51, v8, v35
    v_mov_b32 v50, v25
    s_waitcnt lgkmcnt(0)
    v_add_u32 v7, v7, v45
    v_lshlrev_b32 v7, 3, v7
    buffer_store_dwordx2 v[50:51], v7, s[36:39], s45 offen
    s_nop 1
    v_lshrrev_b32 v6, 3, v16
    v_lshlrev_b32 v6, 2, v6
    ds_read_b32 v7, v6
    v_and_b32 v8, 7, v16
    v_lshlrev_b32 v8, 16, v8
    v_or_b32 v51, v8, v36
    v_mov_b32 v50, v26
    s_waitcnt lgkmcnt(0)
    v_add_u32 v7, v7, v46
    v_lshlrev_b32 v7, 3, v7
    buffer_store_dwordx2 v[50:51], v7, s[36:39], s45 offen
    s_nop 1
    v_lshrrev_b32 v6, 3, v17
    v_lshlrev_b32 v6, 2, v6
    ds_read_b32 v7, v6
    v_and_b32 v8, 7, v17
    v_lshlrev_b32 v8, 16, v8
    v_or_b32 v51, v8, v37
    v_mov_b32 v50, v27
    s_waitcnt lgkmcnt(0)
    v_add_u32 v7, v7, v47
    v_lshlrev_b32 v7, 3, v7
    buffer_store_dwordx2 v[50:51], v7, s[36:39], s45 offen
    s_nop 1
    v_lshrrev_b32 v6, 3, v18
    v_lshlrev_b32 v6, 2, v6
    ds_read_b32 v7, v6
    v_and_b32 v8, 7, v18
    v_lshlrev_b32 v8, 16, v8
    v_or_b32 v51, v8, v38
    v_mov_b32 v50, v28
    s_waitcnt lgkmcnt(0)
    v_add_u32 v7, v7, v48
    v_lshlrev_b32 v7, 3, v7
    buffer_store_dwordx2 v[50:51], v7, s[36:39], s45 offen
    s_nop 1
    s_mov_b64 exec, s[46:47]
    v_lshrrev_b32 v6, 3, v19
    v_lshlrev_b32 v6, 2, v6
    ds_read_b32 v7, v6
    v_and_b32 v8, 7, v19
    v_lshlrev_b32 v8, 16, v8
    v_or_b32 v51, v8, v39
    v_mov_b32 v50, v29
    s_waitcnt lgkmcnt(0)
    v_add_u32 v7, v7, v49
    v_lshlrev_b32 v7, 3, v7
    buffer_store_dwordx2 v[50:51], v7, s[36:39], s45 offen
    s_nop 1
    s_endpgm
L_gemm:
    s_mov_b32 s24, s12
    s_mov_b32 s25, s13
    s_mov_b32 s26, 131584
    s_mov_b32 s27, 0x00020000
    s_mov_b32 s28, s4
    s_mov_b32 s29, s5
    s_mov_b32 s30, 2560000
    s_mov_b32 s31, 0x00020000
    s_mov_b32 s32, s20
    s_mov_b32 s33, s21
    s_mov_b32 s34, 5120000
    s_mov_b32 s35, 0x00020000
    s_add_u32 s36, s20, 8388608
    s_addc_u32 s37, s21, 0
    s_mov_b32 s38, 10240000
    s_mov_b32 s39, 0x00020000
    s_mov_b32 s40, s14
    s_mov_b32 s41, s15
    s_mov_b32 s42, 512
    s_mov_b32 s43, 0x00020000
    s_sub_u32 s44, s2, 64
    v_lshrrev_b32 v1, 6, v0
    s_nop 0
    v_readfirstlane_b32 s45, v1
    v_and_b32 v1, 63, v0
    v_and_b32 v2, 31, v1
    v_lshrrev_b32 v3, 5, v1
    s_lshl_b32 s46, s45, 6
    s_and_b32 s47, s46, 255
    s_cmp_ge_u32 s45, 4
    s_cselect_b32 s48, 128, 0
    v_lshlrev_b32 v4, 3, v3
    v_add_u32 v4, s48, v4
    v_lshlrev_b32 v4, 9, v4
    v_add_u32 v5, s47, v2
    v_lshlrev_b32 v5, 1, v5
    v_add_u32 v4, v4, v5
    s_lshl_b32 s49, s44, 5
    v_add_u32 v6, s49, v2
    v_lshlrev_b32 v7, 8, v6
    v_lshlrev_b32 v8, 4, v3
    v_add_u32 v7, v7, v8
    v_mov_b32 v88, 0
    v_mov_b32 v89, 0
    v_mov_b32 v90, 0
    v_mov_b32 v91, 0
    v_mov_b32 v92, 0
    v_mov_b32 v93, 0
    v_mov_b32 v94, 0
    v_mov_b32 v95, 0
    v_mov_b32 v96, 0
    v_mov_b32 v97, 0
    v_mov_b32 v98, 0
    v_mov_b32 v99, 0
    v_mov_b32 v100, 0
    v_mov_b32 v101, 0
    v_mov_b32 v102, 0
    v_mov_b32 v103, 0
    v_mov_b32 v104, 0
    v_mov_b32 v105, 0
    v_mov_b32 v106, 0
    v_mov_b32 v107, 0
    v_mov_b32 v108, 0
    v_mov_b32 v109, 0
    v_mov_b32 v110, 0
    v_mov_b32 v111, 0
    v_mov_b32 v112, 0
    v_mov_b32 v113, 0
    v_mov_b32 v114, 0
    v_mov_b32 v115, 0
    v_mov_b32 v116, 0
    v_mov_b32 v117, 0
    v_mov_b32 v118, 0
    v_mov_b32 v119, 0
    buffer_load_dwordx4 v[32:35], v7, s[28:31], 0 offen offset:0
    s_mov_b32 s50, 0
    buffer_load_ushort v40, v4, s[24:27], s50 offen offset:0
    buffer_load_ushort v41, v4, s[24:27], s50 offen offset:512
    buffer_load_ushort v42, v4, s[24:27], s50 offen offset:1024
    buffer_load_ushort v43, v4, s[24:27], s50 offen offset:1536
    buffer_load_ushort v44, v4, s[24:27], s50 offen offset:2048
    buffer_load_ushort v45, v4, s[24:27], s50 offen offset:2560
    buffer_load_ushort v46, v4, s[24:27], s50 offen offset:3072
    buffer_load_ushort v47, v4, s[24:27], s50 offen offset:3584
    buffer_load_ushort v48, v4, s[24:27], s50 offen offset:64
    buffer_load_ushort v49, v4, s[24:27], s50 offen offset:576
    buffer_load_ushort v50, v4, s[24:27], s50 offen offset:1088
    buffer_load_ushort v51, v4, s[24:27], s50 offen offset:1600
    buffer_load_ushort v52, v4, s[24:27], s50 offen offset:2112
    buffer_load_ushort v53, v4, s[24:27], s50 offen offset:2624
    buffer_load_ushort v54, v4, s[24:27], s50 offen offset:3136
    buffer_load_ushort v55, v4, s[24:27], s50 offen offset:3648
    buffer_load_dwordx4 v[36:39], v7, s[28:31], 0 offen offset:32
    s_mov_b32 s50, 8192
    buffer_load_ushort v56, v4, s[24:27], s50 offen offset:0
    buffer_load_ushort v57, v4, s[24:27], s50 offen offset:512
    buffer_load_ushort v58, v4, s[24:27], s50 offen offset:1024
    buffer_load_ushort v59, v4, s[24:27], s50 offen offset:1536
    buffer_load_ushort v60, v4, s[24:27], s50 offen offset:2048
    buffer_load_ushort v61, v4, s[24:27], s50 offen offset:2560
    buffer_load_ushort v62, v4, s[24:27], s50 offen offset:3072
    buffer_load_ushort v63, v4, s[24:27], s50 offen offset:3584
    buffer_load_ushort v64, v4, s[24:27], s50 offen offset:64
    buffer_load_ushort v65, v4, s[24:27], s50 offen offset:576
    buffer_load_ushort v66, v4, s[24:27], s50 offen offset:1088
    buffer_load_ushort v67, v4, s[24:27], s50 offen offset:1600
    buffer_load_ushort v68, v4, s[24:27], s50 offen offset:2112
    buffer_load_ushort v69, v4, s[24:27], s50 offen offset:2624
    buffer_load_ushort v70, v4, s[24:27], s50 offen offset:3136
    buffer_load_ushort v71, v4, s[24:27], s50 offen offset:3648
    s_waitcnt vmcnt(0)
    v_lshl_or_b32 v72, v41, 16, v40
    v_lshl_or_b32 v73, v43, 16, v42
    v_lshl_or_b32 v74, v45, 16, v44
    v_lshl_or_b32 v75, v47, 16, v46
    v_lshl_or_b32 v76, v49, 16, v48
    v_lshl_or_b32 v77, v51, 16, v50
    v_lshl_or_b32 v78, v53, 16, v52
    v_lshl_or_b32 v79, v55, 16, v54
    v_lshl_or_b32 v80, v57, 16, v56
    v_lshl_or_b32 v81, v59, 16, v58
    v_lshl_or_b32 v82, v61, 16, v60
    v_lshl_or_b32 v83, v63, 16, v62
    v_lshl_or_b32 v84, v65, 16, v64
    v_lshl_or_b32 v85, v67, 16, v66
    v_lshl_or_b32 v86, v69, 16, v68
    v_lshl_or_b32 v87, v71, 16, v70
    s_nop 1
    v_mfma_f32_32x32x16_bf16 v[88:103], v[72:75], v[32:35], v[88:103]
    v_mfma_f32_32x32x16_bf16 v[104:119], v[76:79], v[32:35], v[104:119]
    v_mfma_f32_32x32x16_bf16 v[88:103], v[80:83], v[36:39], v[88:103]
    v_mfma_f32_32x32x16_bf16 v[104:119], v[84:87], v[36:39], v[104:119]
    s_nop 7
    buffer_load_dwordx4 v[32:35], v7, s[28:31], 0 offen offset:64
    s_mov_b32 s50, 16384
    buffer_load_ushort v40, v4, s[24:27], s50 offen offset:0
    buffer_load_ushort v41, v4, s[24:27], s50 offen offset:512
    buffer_load_ushort v42, v4, s[24:27], s50 offen offset:1024
    buffer_load_ushort v43, v4, s[24:27], s50 offen offset:1536
    buffer_load_ushort v44, v4, s[24:27], s50 offen offset:2048
    buffer_load_ushort v45, v4, s[24:27], s50 offen offset:2560
    buffer_load_ushort v46, v4, s[24:27], s50 offen offset:3072
    buffer_load_ushort v47, v4, s[24:27], s50 offen offset:3584
    buffer_load_ushort v48, v4, s[24:27], s50 offen offset:64
    buffer_load_ushort v49, v4, s[24:27], s50 offen offset:576
    buffer_load_ushort v50, v4, s[24:27], s50 offen offset:1088
    buffer_load_ushort v51, v4, s[24:27], s50 offen offset:1600
    buffer_load_ushort v52, v4, s[24:27], s50 offen offset:2112
    buffer_load_ushort v53, v4, s[24:27], s50 offen offset:2624
    buffer_load_ushort v54, v4, s[24:27], s50 offen offset:3136
    buffer_load_ushort v55, v4, s[24:27], s50 offen offset:3648
    buffer_load_dwordx4 v[36:39], v7, s[28:31], 0 offen offset:96
    s_mov_b32 s50, 24576
    buffer_load_ushort v56, v4, s[24:27], s50 offen offset:0
    buffer_load_ushort v57, v4, s[24:27], s50 offen offset:512
    buffer_load_ushort v58, v4, s[24:27], s50 offen offset:1024
    buffer_load_ushort v59, v4, s[24:27], s50 offen offset:1536
    buffer_load_ushort v60, v4, s[24:27], s50 offen offset:2048
    buffer_load_ushort v61, v4, s[24:27], s50 offen offset:2560
    buffer_load_ushort v62, v4, s[24:27], s50 offen offset:3072
    buffer_load_ushort v63, v4, s[24:27], s50 offen offset:3584
    buffer_load_ushort v64, v4, s[24:27], s50 offen offset:64
    buffer_load_ushort v65, v4, s[24:27], s50 offen offset:576
    buffer_load_ushort v66, v4, s[24:27], s50 offen offset:1088
    buffer_load_ushort v67, v4, s[24:27], s50 offen offset:1600
    buffer_load_ushort v68, v4, s[24:27], s50 offen offset:2112
    buffer_load_ushort v69, v4, s[24:27], s50 offen offset:2624
    buffer_load_ushort v70, v4, s[24:27], s50 offen offset:3136
    buffer_load_ushort v71, v4, s[24:27], s50 offen offset:3648
    s_waitcnt vmcnt(0)
    v_lshl_or_b32 v72, v41, 16, v40
    v_lshl_or_b32 v73, v43, 16, v42
    v_lshl_or_b32 v74, v45, 16, v44
    v_lshl_or_b32 v75, v47, 16, v46
    v_lshl_or_b32 v76, v49, 16, v48
    v_lshl_or_b32 v77, v51, 16, v50
    v_lshl_or_b32 v78, v53, 16, v52
    v_lshl_or_b32 v79, v55, 16, v54
    v_lshl_or_b32 v80, v57, 16, v56
    v_lshl_or_b32 v81, v59, 16, v58
    v_lshl_or_b32 v82, v61, 16, v60
    v_lshl_or_b32 v83, v63, 16, v62
    v_lshl_or_b32 v84, v65, 16, v64
    v_lshl_or_b32 v85, v67, 16, v66
    v_lshl_or_b32 v86, v69, 16, v68
    v_lshl_or_b32 v87, v71, 16, v70
    s_nop 1
    v_mfma_f32_32x32x16_bf16 v[88:103], v[72:75], v[32:35], v[88:103]
    v_mfma_f32_32x32x16_bf16 v[104:119], v[76:79], v[32:35], v[104:119]
    v_mfma_f32_32x32x16_bf16 v[88:103], v[80:83], v[36:39], v[88:103]
    v_mfma_f32_32x32x16_bf16 v[104:119], v[84:87], v[36:39], v[104:119]
    s_nop 7
    buffer_load_dwordx4 v[32:35], v7, s[28:31], 0 offen offset:128
    s_mov_b32 s50, 32768
    buffer_load_ushort v40, v4, s[24:27], s50 offen offset:0
    buffer_load_ushort v41, v4, s[24:27], s50 offen offset:512
    buffer_load_ushort v42, v4, s[24:27], s50 offen offset:1024
    buffer_load_ushort v43, v4, s[24:27], s50 offen offset:1536
    buffer_load_ushort v44, v4, s[24:27], s50 offen offset:2048
    buffer_load_ushort v45, v4, s[24:27], s50 offen offset:2560
    buffer_load_ushort v46, v4, s[24:27], s50 offen offset:3072
    buffer_load_ushort v47, v4, s[24:27], s50 offen offset:3584
    buffer_load_ushort v48, v4, s[24:27], s50 offen offset:64
    buffer_load_ushort v49, v4, s[24:27], s50 offen offset:576
    buffer_load_ushort v50, v4, s[24:27], s50 offen offset:1088
    buffer_load_ushort v51, v4, s[24:27], s50 offen offset:1600
    buffer_load_ushort v52, v4, s[24:27], s50 offen offset:2112
    buffer_load_ushort v53, v4, s[24:27], s50 offen offset:2624
    buffer_load_ushort v54, v4, s[24:27], s50 offen offset:3136
    buffer_load_ushort v55, v4, s[24:27], s50 offen offset:3648
    buffer_load_dwordx4 v[36:39], v7, s[28:31], 0 offen offset:160
    s_mov_b32 s50, 40960
    buffer_load_ushort v56, v4, s[24:27], s50 offen offset:0
    buffer_load_ushort v57, v4, s[24:27], s50 offen offset:512
    buffer_load_ushort v58, v4, s[24:27], s50 offen offset:1024
    buffer_load_ushort v59, v4, s[24:27], s50 offen offset:1536
    buffer_load_ushort v60, v4, s[24:27], s50 offen offset:2048
    buffer_load_ushort v61, v4, s[24:27], s50 offen offset:2560
    buffer_load_ushort v62, v4, s[24:27], s50 offen offset:3072
    buffer_load_ushort v63, v4, s[24:27], s50 offen offset:3584
    buffer_load_ushort v64, v4, s[24:27], s50 offen offset:64
    buffer_load_ushort v65, v4, s[24:27], s50 offen offset:576
    buffer_load_ushort v66, v4, s[24:27], s50 offen offset:1088
    buffer_load_ushort v67, v4, s[24:27], s50 offen offset:1600
    buffer_load_ushort v68, v4, s[24:27], s50 offen offset:2112
    buffer_load_ushort v69, v4, s[24:27], s50 offen offset:2624
    buffer_load_ushort v70, v4, s[24:27], s50 offen offset:3136
    buffer_load_ushort v71, v4, s[24:27], s50 offen offset:3648
    s_waitcnt vmcnt(0)
    v_lshl_or_b32 v72, v41, 16, v40
    v_lshl_or_b32 v73, v43, 16, v42
    v_lshl_or_b32 v74, v45, 16, v44
    v_lshl_or_b32 v75, v47, 16, v46
    v_lshl_or_b32 v76, v49, 16, v48
    v_lshl_or_b32 v77, v51, 16, v50
    v_lshl_or_b32 v78, v53, 16, v52
    v_lshl_or_b32 v79, v55, 16, v54
    v_lshl_or_b32 v80, v57, 16, v56
    v_lshl_or_b32 v81, v59, 16, v58
    v_lshl_or_b32 v82, v61, 16, v60
    v_lshl_or_b32 v83, v63, 16, v62
    v_lshl_or_b32 v84, v65, 16, v64
    v_lshl_or_b32 v85, v67, 16, v66
    v_lshl_or_b32 v86, v69, 16, v68
    v_lshl_or_b32 v87, v71, 16, v70
    s_nop 1
    v_mfma_f32_32x32x16_bf16 v[88:103], v[72:75], v[32:35], v[88:103]
    v_mfma_f32_32x32x16_bf16 v[104:119], v[76:79], v[32:35], v[104:119]
    v_mfma_f32_32x32x16_bf16 v[88:103], v[80:83], v[36:39], v[88:103]
    v_mfma_f32_32x32x16_bf16 v[104:119], v[84:87], v[36:39], v[104:119]
    s_nop 7
    buffer_load_dwordx4 v[32:35], v7, s[28:31], 0 offen offset:192
    s_mov_b32 s50, 49152
    buffer_load_ushort v40, v4, s[24:27], s50 offen offset:0
    buffer_load_ushort v41, v4, s[24:27], s50 offen offset:512
    buffer_load_ushort v42, v4, s[24:27], s50 offen offset:1024
    buffer_load_ushort v43, v4, s[24:27], s50 offen offset:1536
    buffer_load_ushort v44, v4, s[24:27], s50 offen offset:2048
    buffer_load_ushort v45, v4, s[24:27], s50 offen offset:2560
    buffer_load_ushort v46, v4, s[24:27], s50 offen offset:3072
    buffer_load_ushort v47, v4, s[24:27], s50 offen offset:3584
    buffer_load_ushort v48, v4, s[24:27], s50 offen offset:64
    buffer_load_ushort v49, v4, s[24:27], s50 offen offset:576
    buffer_load_ushort v50, v4, s[24:27], s50 offen offset:1088
    buffer_load_ushort v51, v4, s[24:27], s50 offen offset:1600
    buffer_load_ushort v52, v4, s[24:27], s50 offen offset:2112
    buffer_load_ushort v53, v4, s[24:27], s50 offen offset:2624
    buffer_load_ushort v54, v4, s[24:27], s50 offen offset:3136
    buffer_load_ushort v55, v4, s[24:27], s50 offen offset:3648
    buffer_load_dwordx4 v[36:39], v7, s[28:31], 0 offen offset:224
    s_mov_b32 s50, 57344
    buffer_load_ushort v56, v4, s[24:27], s50 offen offset:0
    buffer_load_ushort v57, v4, s[24:27], s50 offen offset:512
    buffer_load_ushort v58, v4, s[24:27], s50 offen offset:1024
    buffer_load_ushort v59, v4, s[24:27], s50 offen offset:1536
    buffer_load_ushort v60, v4, s[24:27], s50 offen offset:2048
    buffer_load_ushort v61, v4, s[24:27], s50 offen offset:2560
    buffer_load_ushort v62, v4, s[24:27], s50 offen offset:3072
    buffer_load_ushort v63, v4, s[24:27], s50 offen offset:3584
    buffer_load_ushort v64, v4, s[24:27], s50 offen offset:64
    buffer_load_ushort v65, v4, s[24:27], s50 offen offset:576
    buffer_load_ushort v66, v4, s[24:27], s50 offen offset:1088
    buffer_load_ushort v67, v4, s[24:27], s50 offen offset:1600
    buffer_load_ushort v68, v4, s[24:27], s50 offen offset:2112
    buffer_load_ushort v69, v4, s[24:27], s50 offen offset:2624
    buffer_load_ushort v70, v4, s[24:27], s50 offen offset:3136
    buffer_load_ushort v71, v4, s[24:27], s50 offen offset:3648
    s_waitcnt vmcnt(0)
    v_lshl_or_b32 v72, v41, 16, v40
    v_lshl_or_b32 v73, v43, 16, v42
    v_lshl_or_b32 v74, v45, 16, v44
    v_lshl_or_b32 v75, v47, 16, v46
    v_lshl_or_b32 v76, v49, 16, v48
    v_lshl_or_b32 v77, v51, 16, v50
    v_lshl_or_b32 v78, v53, 16, v52
    v_lshl_or_b32 v79, v55, 16, v54
    v_lshl_or_b32 v80, v57, 16, v56
    v_lshl_or_b32 v81, v59, 16, v58
    v_lshl_or_b32 v82, v61, 16, v60
    v_lshl_or_b32 v83, v63, 16, v62
    v_lshl_or_b32 v84, v65, 16, v64
    v_lshl_or_b32 v85, v67, 16, v66
    v_lshl_or_b32 v86, v69, 16, v68
    v_lshl_or_b32 v87, v71, 16, v70
    s_nop 1
    v_mfma_f32_32x32x16_bf16 v[88:103], v[72:75], v[32:35], v[88:103]
    v_mfma_f32_32x32x16_bf16 v[104:119], v[76:79], v[32:35], v[104:119]
    v_mfma_f32_32x32x16_bf16 v[88:103], v[80:83], v[36:39], v[88:103]
    v_mfma_f32_32x32x16_bf16 v[104:119], v[84:87], v[36:39], v[104:119]
    s_nop 7
    s_nop 15
    s_nop 7
    s_mov_b32 s51, 3216550459
    s_cmp_ge_u32 s45, 4
    s_cbranch_scc1 L_gemm_q
    v_lshlrev_b32 v9, 9, v6
    v_lshlrev_b32 v10, 3, v3
    v_add_u32 v9, v9, v10
    s_lshl_b32 s52, s46, 1
    v_mul_f32 v88, s51, v88
    v_mul_f32 v89, s51, v89
    v_mul_f32 v90, s51, v90
    v_mul_f32 v91, s51, v91
    v_cvt_pk_bf16_f32 v12, v88, v89
    v_cvt_pk_bf16_f32 v13, v90, v91
    buffer_store_dwordx2 v[12:13], v9, s[32:35], s52 offen offset:0
    s_nop 1
    v_mul_f32 v92, s51, v92
    v_mul_f32 v93, s51, v93
    v_mul_f32 v94, s51, v94
    v_mul_f32 v95, s51, v95
    v_cvt_pk_bf16_f32 v12, v92, v93
    v_cvt_pk_bf16_f32 v13, v94, v95
    buffer_store_dwordx2 v[12:13], v9, s[32:35], s52 offen offset:16
    s_nop 1
    v_mul_f32 v96, s51, v96
    v_mul_f32 v97, s51, v97
    v_mul_f32 v98, s51, v98
    v_mul_f32 v99, s51, v99
    v_cvt_pk_bf16_f32 v12, v96, v97
    v_cvt_pk_bf16_f32 v13, v98, v99
    buffer_store_dwordx2 v[12:13], v9, s[32:35], s52 offen offset:32
    s_nop 1
    v_mul_f32 v100, s51, v100
    v_mul_f32 v101, s51, v101
    v_mul_f32 v102, s51, v102
    v_mul_f32 v103, s51, v103
    v_cvt_pk_bf16_f32 v12, v100, v101
    v_cvt_pk_bf16_f32 v13, v102, v103
    buffer_store_dwordx2 v[12:13], v9, s[32:35], s52 offen offset:48
    s_nop 1
    v_mul_f32 v104, s51, v104
    v_mul_f32 v105, s51, v105
    v_mul_f32 v106, s51, v106
    v_mul_f32 v107, s51, v107
    v_cvt_pk_bf16_f32 v12, v104, v105
    v_cvt_pk_bf16_f32 v13, v106, v107
    buffer_store_dwordx2 v[12:13], v9, s[32:35], s52 offen offset:64
    s_nop 1
    v_mul_f32 v108, s51, v108
    v_mul_f32 v109, s51, v109
    v_mul_f32 v110, s51, v110
    v_mul_f32 v111, s51, v111
    v_cvt_pk_bf16_f32 v12, v108, v109
    v_cvt_pk_bf16_f32 v13, v110, v111
    buffer_store_dwordx2 v[12:13], v9, s[32:35], s52 offen offset:80
    s_nop 1
    v_mul_f32 v112, s51, v112
    v_mul_f32 v113, s51, v113
    v_mul_f32 v114, s51, v114
    v_mul_f32 v115, s51, v115
    v_cvt_pk_bf16_f32 v12, v112, v113
    v_cvt_pk_bf16_f32 v13, v114, v115
    buffer_store_dwordx2 v[12:13], v9, s[32:35], s52 offen offset:96
    s_nop 1
    v_mul_f32 v116, s51, v116
    v_mul_f32 v117, s51, v117
    v_mul_f32 v118, s51, v118
    v_mul_f32 v119, s51, v119
    v_cvt_pk_bf16_f32 v12, v116, v117
    v_cvt_pk_bf16_f32 v13, v118, v119
    buffer_store_dwordx2 v[12:13], v9, s[32:35], s52 offen offset:112
    s_nop 1
    s_endpgm
L_gemm_q:
    v_lshlrev_b32 v10, 3, v3
    s_lshl_b32 s52, s47, 1
    buffer_load_dwordx2 v[16:17], v10, s[40:43], s52 offen offset:0
    buffer_load_dwordx2 v[18:19], v10, s[40:43], s52 offen offset:16
    buffer_load_dwordx2 v[20:21], v10, s[40:43], s52 offen offset:32
    buffer_load_dwordx2 v[22:23], v10, s[40:43], s52 offen offset:48
    buffer_load_dwordx2 v[24:25], v10, s[40:43], s52 offen offset:64
    buffer_load_dwordx2 v[26:27], v10, s[40:43], s52 offen offset:80
    buffer_load_dwordx2 v[28:29], v10, s[40:43], s52 offen offset:96
    buffer_load_dwordx2 v[30:31], v10, s[40:43], s52 offen offset:112
    v_lshlrev_b32 v9, 10, v6
    v_lshlrev_b32 v10, 4, v3
    v_add_u32 v9, v9, v10
    s_lshl_b32 s52, s47, 2
    s_waitcnt vmcnt(0)
    v_lshlrev_b32 v12, 16, v16
    v_and_b32 v13, 0xffff0000, v16
    v_lshlrev_b32 v14, 16, v17
    v_and_b32 v15, 0xffff0000, v17
    v_add_f32 v88, v88, v12
    v_mul_f32 v88, s51, v88
    v_add_f32 v89, v89, v13
    v_mul_f32 v89, s51, v89
    v_add_f32 v90, v90, v14
    v_mul_f32 v90, s51, v90
    v_add_f32 v91, v91, v15
    v_mul_f32 v91, s51, v91
    buffer_store_dwordx4 v[88:91], v9, s[36:39], s52 offen offset:0
    v_lshlrev_b32 v12, 16, v18
    v_and_b32 v13, 0xffff0000, v18
    v_lshlrev_b32 v14, 16, v19
    v_and_b32 v15, 0xffff0000, v19
    v_add_f32 v92, v92, v12
    v_mul_f32 v92, s51, v92
    v_add_f32 v93, v93, v13
    v_mul_f32 v93, s51, v93
    v_add_f32 v94, v94, v14
    v_mul_f32 v94, s51, v94
    v_add_f32 v95, v95, v15
    v_mul_f32 v95, s51, v95
    buffer_store_dwordx4 v[92:95], v9, s[36:39], s52 offen offset:32
    v_lshlrev_b32 v12, 16, v20
    v_and_b32 v13, 0xffff0000, v20
    v_lshlrev_b32 v14, 16, v21
    v_and_b32 v15, 0xffff0000, v21
    v_add_f32 v96, v96, v12
    v_mul_f32 v96, s51, v96
    v_add_f32 v97, v97, v13
    v_mul_f32 v97, s51, v97
    v_add_f32 v98, v98, v14
    v_mul_f32 v98, s51, v98
    v_add_f32 v99, v99, v15
    v_mul_f32 v99, s51, v99
    buffer_store_dwordx4 v[96:99], v9, s[36:39], s52 offen offset:64
    v_lshlrev_b32 v12, 16, v22
    v_and_b32 v13, 0xffff0000, v22
    v_lshlrev_b32 v14, 16, v23
    v_and_b32 v15, 0xffff0000, v23
    v_add_f32 v100, v100, v12
    v_mul_f32 v100, s51, v100
    v_add_f32 v101, v101, v13
    v_mul_f32 v101, s51, v101
    v_add_f32 v102, v102, v14
    v_mul_f32 v102, s51, v102
    v_add_f32 v103, v103, v15
    v_mul_f32 v103, s51, v103
    buffer_store_dwordx4 v[100:103], v9, s[36:39], s52 offen offset:96
    v_lshlrev_b32 v12, 16, v24
    v_and_b32 v13, 0xffff0000, v24
    v_lshlrev_b32 v14, 16, v25
    v_and_b32 v15, 0xffff0000, v25
    v_add_f32 v104, v104, v12
    v_mul_f32 v104, s51, v104
    v_add_f32 v105, v105, v13
    v_mul_f32 v105, s51, v105
    v_add_f32 v106, v106, v14
    v_mul_f32 v106, s51, v106
    v_add_f32 v107, v107, v15
    v_mul_f32 v107, s51, v107
    buffer_store_dwordx4 v[104:107], v9, s[36:39], s52 offen offset:128
    v_lshlrev_b32 v12, 16, v26
    v_and_b32 v13, 0xffff0000, v26
    v_lshlrev_b32 v14, 16, v27
    v_and_b32 v15, 0xffff0000, v27
    v_add_f32 v108, v108, v12
    v_mul_f32 v108, s51, v108
    v_add_f32 v109, v109, v13
    v_mul_f32 v109, s51, v109
    v_add_f32 v110, v110, v14
    v_mul_f32 v110, s51, v110
    v_add_f32 v111, v111, v15
    v_mul_f32 v111, s51, v111
    buffer_store_dwordx4 v[108:111], v9, s[36:39], s52 offen offset:160
    v_lshlrev_b32 v12, 16, v28
    v_and_b32 v13, 0xffff0000, v28
    v_lshlrev_b32 v14, 16, v29
    v_and_b32 v15, 0xffff0000, v29
    v_add_f32 v112, v112, v12
    v_mul_f32 v112, s51, v112
    v_add_f32 v113, v113, v13
    v_mul_f32 v113, s51, v113
    v_add_f32 v114, v114, v14
    v_mul_f32 v114, s51, v114
    v_add_f32 v115, v115, v15
    v_mul_f32 v115, s51, v115
    buffer_store_dwordx4 v[112:115], v9, s[36:39], s52 offen offset:192
    v_lshlrev_b32 v12, 16, v30
    v_and_b32 v13, 0xffff0000, v30
    v_lshlrev_b32 v14, 16, v31
    v_and_b32 v15, 0xffff0000, v31
    v_add_f32 v116, v116, v12
    v_mul_f32 v116, s51, v116
    v_add_f32 v117, v117, v13
    v_mul_f32 v117, s51, v117
    v_add_f32 v118, v118, v14
    v_mul_f32 v118, s51, v118
    v_add_f32 v119, v119, v15
    v_mul_f32 v119, s51, v119
    buffer_store_dwordx4 v[116:119], v9, s[36:39], s52 offen offset:224
    s_endpgm
L_w2t:
    s_mov_b32 s24, s16
    s_mov_b32 s25, s17
    s_mov_b32 s26, 65536
    s_mov_b32 s27, 0x00020000
    s_add_u32 s28, s20, 39845888
    s_addc_u32 s29, s21, 0
    s_mov_b32 s30, 65536
    s_mov_b32 s31, 0x00020000
    s_add_u32 s32, s12, 131072
    s_addc_u32 s33, s13, 0
    s_mov_b32 s34, 512
    s_mov_b32 s35, 0x00020000
    s_add_u32 s36, s20, 39976960
    s_addc_u32 s37, s21, 0
    s_mov_b32 s38, 1024
    s_mov_b32 s39, 0x00020000
    v_lshlrev_b32 v1, 1, v0
    v_lshrrev_b32 v2, 7, v0
    v_and_b32 v3, 127, v0
    v_lshlrev_b32 v3, 9, v3
    v_lshl_add_u32 v3, v2, 1, v3
    s_sub_u32 s43, s2, 377
    s_lshl_b32 s40, s43, 11
    s_lshl_b32 s44, s43, 4
    buffer_load_ushort v10, v1, s[24:27], s40 offen
    buffer_load_ushort v11, v1, s[24:27], s40 offen offset:1024
    s_waitcnt vmcnt(0)
    buffer_store_short v10, v3, s[28:31], s44 offen
    buffer_store_short v11, v3, s[28:31], s44 offen offset:8
    s_cmp_lg_u32 s43, 0
    s_cbranch_scc1 L_prep_end
    v_cmp_gt_u32 vcc, 256, v0
    s_and_saveexec_b64 s[40:41], vcc
    s_cbranch_execz L_prep_end
    buffer_load_ushort v4, v1, s[32:35], 0 offen
    s_mov_b32 s42, 3216550459
    v_lshlrev_b32 v5, 2, v0
    s_waitcnt vmcnt(0)
    v_lshlrev_b32 v4, 16, v4
    v_mul_f32 v4, s42, v4
    buffer_store_dword v4, v5, s[36:39], 0 offen
L_prep_end:
    s_endpgm
.globl main_kernel
.p2align 8
.type main_kernel,@function
main_kernel:
    s_load_dwordx2 s[4:5], s[0:1], 80
    s_load_dwordx2 s[6:7], s[0:1], 64
    s_load_dwordx2 s[40:41], s[0:1], 56
    s_waitcnt lgkmcnt(0)
    s_cmp_ge_u32 s2, 1250
    s_cbranch_scc1 L_main_end
    s_mov_b32 s8, s4
    s_mov_b32 s9, s5
    s_mov_b32 s10, 5120000
    s_mov_b32 s11, 0x00020000
    s_add_u32 s12, s4, 33554432
    s_addc_u32 s13, s5, 0
    s_mov_b32 s14, 2560000
    s_mov_b32 s15, 0x00020000
    s_add_u32 s16, s4, 37748736
    s_addc_u32 s17, s5, 0
    s_mov_b32 s18, 327680
    s_mov_b32 s19, 0x00020000
    s_add_u32 s20, s4, 8388608
    s_addc_u32 s21, s5, 0
    s_mov_b32 s22, 10240000
    s_mov_b32 s23, 0x00020000
    s_add_u32 s24, s4, 39845888
    s_addc_u32 s25, s5, 0
    s_mov_b32 s26, 65536
    s_mov_b32 s27, 0x00020000
    s_mov_b32 s28, s6
    s_mov_b32 s29, s7
    s_mov_b32 s30, 2560000
    s_mov_b32 s31, 0x00020000
    s_add_u32 s32, s4, 39976960
    s_addc_u32 s33, s5, 0
    s_mov_b32 s34, 1024
    s_mov_b32 s35, 0x00020000
    s_mov_b32 s36, s40
    s_mov_b32 s37, s41
    s_mov_b32 s38, 256
    s_mov_b32 s39, 0x00020000
    v_and_b32 v2, 63, v0
    v_lshlrev_b32 v1, 3, v2
    v_lshlrev_b32 v3, 4, v2
    v_lshrrev_b32 v46, 6, v0
    s_nop 0
    v_readfirstlane_b32 s3, v46
    v_lshlrev_b32 v46, 6, v0
    s_lshl_b32 s42, s2, 13
    buffer_load_dwordx4 v[4:7], v3, s[32:35], 0 offen
    v_mov_b32 v64, 0
    v_mov_b32 v65, 0
    v_mov_b32 v66, 0
    v_mov_b32 v67, 0
    v_cmp_gt_u32 vcc, 128, v0
    s_and_saveexec_b64 s[76:77], vcc
    buffer_load_dwordx4 v[48:51], v46, s[20:23], s42 offen offset:0
    buffer_load_dwordx4 v[52:55], v46, s[20:23], s42 offen offset:16
    buffer_load_dwordx4 v[56:59], v46, s[20:23], s42 offen offset:32
    buffer_load_dwordx4 v[60:63], v46, s[20:23], s42 offen offset:48
    ds_write_b128 v46, v[64:67] offset:0
    ds_write_b128 v46, v[64:67] offset:16
    ds_write_b128 v46, v[64:67] offset:32
    ds_write_b128 v46, v[64:67] offset:48
    s_mov_b64 exec, s[76:77]
    v_lshlrev_b32 v47, 2, v0
    v_cmp_gt_u32 vcc, 8, v0
    s_and_saveexec_b64 s[44:45], vcc
    ds_write_b32 v47, v64 offset:25728
    s_mov_b64 exec, s[44:45]
    v_cmp_gt_u32 vcc, 64, v0
    s_and_saveexec_b64 s[44:45], vcc
    s_cbranch_execz L_b_done
    v_mul_u32_u24 v68, 5120, v0
    s_lshl_b32 s42, s2, 2
    buffer_load_dwordx2 v[70:71], v68, s[16:19], s42 offen
    s_waitcnt vmcnt(0)
    v_sub_u32 v72, v71, v70
    v_mov_b32 v73, v72
    s_nop 1
    v_add_u32_dpp v73, v73, v73 row_shr:1 row_mask:0xf bank_mask:0xf bound_ctrl:0
    s_nop 1
    v_add_u32_dpp v73, v73, v73 row_shr:2 row_mask:0xf bank_mask:0xf bound_ctrl:0
    s_nop 1
    v_add_u32_dpp v73, v73, v73 row_shr:4 row_mask:0xf bank_mask:0xf bound_ctrl:0
    s_nop 1
    v_add_u32_dpp v73, v73, v73 row_shr:8 row_mask:0xf bank_mask:0xf bound_ctrl:0
    s_nop 1
    v_add_u32_dpp v73, v73, v73 row_bcast:15 row_mask:0xa bank_mask:0xf
    s_nop 1
    v_add_u32_dpp v73, v73, v73 row_bcast:31 row_mask:0xc bank_mask:0xf
    v_sub_u32 v74, v73, v72
    v_mul_u32_u24 v75, 5000, v0
    v_add_u32 v75, v75, v70
    ds_write_b32 v47, v74 offset:25856
    ds_write_b32 v47, v75 offset:26112
    ds_write_b32 v47, v72 offset:26368
    v_cmp_eq_u32 vcc, 63, v0
    s_and_b64 exec, exec, vcc
    v_mov_b32 v76, 0
    ds_write_b32 v76, v73 offset:26624
L_b_done:
    s_mov_b64 exec, s[44:45]
    s_waitcnt vmcnt(0)
    v_cmp_gt_u32 vcc, 128, v0
    s_and_saveexec_b64 s[76:77], vcc
    ds_write_b128 v46, v[48:51] offset:8192
    ds_write_b128 v46, v[52:55] offset:8208
    ds_write_b128 v46, v[56:59] offset:8224
    ds_write_b128 v46, v[60:63] offset:8240
    s_mov_b64 exec, s[76:77]
    s_waitcnt lgkmcnt(0)
    s_barrier
    v_mov_b32 v76, 0
    ds_read_b32 v77, v76 offset:26624
    v_lshrrev_b32 v78, 2, v0
    v_lshlrev_b32 v78, 2, v78
    ds_read_b32 v79, v78 offset:25856
    ds_read_b32 v80, v78 offset:26112
    ds_read_b32 v81, v78 offset:26368
    s_waitcnt lgkmcnt(0)
    v_readfirstlane_b32 s46, v77
    s_mov_b32 s47, 0
L_batch:
    s_cmp_ge_u32 s47, s46
    s_cbranch_scc1 L_final
    v_cmp_gt_u32 vcc, 8, v0
    s_and_saveexec_b64 s[44:45], vcc
    ds_write_b32 v47, v64 offset:25600
    s_mov_b64 exec, s[44:45]
    s_waitcnt lgkmcnt(0)
    s_barrier
    v_and_b32 v82, 3, v0
L_copy:
    v_cmp_lt_u32 vcc, v82, v81
    s_and_saveexec_b64 s[44:45], vcc
    s_cbranch_execz L_copy_done
    v_add_u32 v83, v79, v82
    v_subrev_u32 v83, s47, v83
    v_cmp_gt_u32 vcc, 512, v83
    s_and_saveexec_b64 s[48:49], vcc
    s_cbranch_execz L_copy_skip
    v_add_u32 v84, v80, v82
    v_lshlrev_b32 v84, 3, v84
    buffer_load_dwordx2 v[86:87], v84, s[12:15], 0 offen
    v_mov_b32 v85, 1
    s_waitcnt vmcnt(0)
    v_lshrrev_b32 v88, 16, v87
    v_lshlrev_b32 v89, 2, v88
    ds_add_rtn_u32 v90, v89, v85 offset:25600
    v_lshlrev_b32 v87, 16, v87
    v_or_b32 v87, v87, v88
    v_lshlrev_b32 v83, 3, v83
    s_waitcnt lgkmcnt(0)
    v_lshl_or_b32 v86, v90, 16, v86
    ds_write_b64 v83, v[86:87] offset:16384
L_copy_skip:
    s_mov_b64 exec, s[44:45]
    v_add_u32 v82, 4, v82
    s_branch L_copy
L_copy_done:
    s_mov_b64 exec, s[44:45]
    s_waitcnt lgkmcnt(0)
    s_barrier
    v_mov_b32 v76, 0
    ds_read_b128 v[92:95], v76 offset:25600
    ds_read_b128 v[96:99], v76 offset:25616
    s_waitcnt lgkmcnt(0)
    v_mov_b32 v100, 0
    v_add_u32 v101, v100, v92
    v_add_u32 v102, v101, v93
    v_add_u32 v103, v102, v94
    v_add_u32 v104, v103, v95
    v_add_u32 v105, v104, v96
    v_add_u32 v106, v105, v97
    v_add_u32 v107, v106, v98
    v_add_u32 v108, v107, v99
    v_cmp_eq_u32 vcc, 0, v0
    s_and_saveexec_b64 s[44:45], vcc
    ds_write_b128 v76, v[100:103] offset:25664
    ds_write_b128 v76, v[104:107] offset:25680
    ds_write_b32 v76, v108 offset:25696
    ds_add_u32 v76, v92 offset:25728
    ds_add_u32 v76, v93 offset:25732
    ds_add_u32 v76, v94 offset:25736
    ds_add_u32 v76, v95 offset:25740
    ds_add_u32 v76, v96 offset:25744
    ds_add_u32 v76, v97 offset:25748
    ds_add_u32 v76, v98 offset:25752
    ds_add_u32 v76, v99 offset:25756
    s_mov_b64 exec, s[44:45]
    s_waitcnt lgkmcnt(0)
    s_barrier
    s_sub_u32 s48, s46, s47
    s_min_u32 s48, s48, 512
    v_mov_b32 v82, v0
L_move:
    v_cmp_gt_u32 vcc, s48, v82
    s_and_saveexec_b64 s[44:45], vcc
    s_cbranch_execz L_move_done
    v_lshlrev_b32 v83, 3, v82
    ds_read_b64 v[86:87], v83 offset:16384
    s_waitcnt lgkmcnt(0)
    v_and_b32 v88, 7, v87
    v_lshlrev_b32 v88, 2, v88
    ds_read_b32 v89, v88 offset:25664
    v_lshrrev_b32 v90, 16, v86
    v_and_b32 v86, 0xffff, v86
    v_lshlrev_b32 v86, 9, v86
    s_waitcnt lgkmcnt(0)
    v_add_u32 v89, v89, v90
    v_lshlrev_b32 v89, 3, v89
    ds_write_b64 v89, v[86:87] offset:20480
    s_mov_b64 exec, s[44:45]
    v_add_u32 v82, 256, v82
    s_branch L_move
L_move_done:
    s_mov_b64 exec, s[44:45]
    s_waitcnt lgkmcnt(0)
    s_barrier
    s_lshl_b32 s48, s3, 3
    v_mov_b32 v76, s48
    ds_read_b32 v77, v76 offset:25664
    ds_read_b32 v78, v76 offset:25672
    s_waitcnt lgkmcnt(0)
    v_readfirstlane_b32 s50, v77
    v_readfirstlane_b32 s51, v78
    s_nop 3
    s_cmp_ge_u32 s50, s51
    s_cbranch_scc1 L_edges_done
    s_mov_b32 s52, s50
    s_lshl_b32 s53, s52, 3
    v_add_u32 v76, s53, v1
    ds_read_b64 v[32:33], v76 offset:20480
    s_waitcnt lgkmcnt(0)
    v_readlane_b32 s54, v32, 0
    v_readlane_b32 s55, v33, 0
    s_nop 4
    s_and_b32 s60, s55, 0xffff0000
    s_and_b32 s68, s55, 7
    buffer_load_dwordx2 v[16:17], v1, s[8:11], s54 offen
    v_readlane_b32 s54, v32, 1
    v_readlane_b32 s55, v33, 1
    s_nop 4
    s_and_b32 s61, s55, 0xffff0000
    s_and_b32 s69, s55, 7
    buffer_load_dwordx2 v[18:19], v1, s[8:11], s54 offen
    v_readlane_b32 s54, v32, 2
    v_readlane_b32 s55, v33, 2
    s_nop 4
    s_and_b32 s62, s55, 0xffff0000
    s_and_b32 s70, s55, 7
    buffer_load_dwordx2 v[20:21], v1, s[8:11], s54 offen
    v_readlane_b32 s54, v32, 3
    v_readlane_b32 s55, v33, 3
    s_nop 4
    s_and_b32 s63, s55, 0xffff0000
    s_and_b32 s71, s55, 7
    buffer_load_dwordx2 v[22:23], v1, s[8:11], s54 offen
    v_readlane_b32 s54, v32, 4
    v_readlane_b32 s55, v33, 4
    s_nop 4
    s_and_b32 s64, s55, 0xffff0000
    s_and_b32 s72, s55, 7
    buffer_load_dwordx2 v[24:25], v1, s[8:11], s54 offen
    v_readlane_b32 s54, v32, 5
    v_readlane_b32 s55, v33, 5
    s_nop 4
    s_and_b32 s65, s55, 0xffff0000
    s_and_b32 s73, s55, 7
    buffer_load_dwordx2 v[26:27], v1, s[8:11], s54 offen
    v_readlane_b32 s54, v32, 6
    v_readlane_b32 s55, v33, 6
    s_nop 4
    s_and_b32 s66, s55, 0xffff0000
    s_and_b32 s74, s55, 7
    buffer_load_dwordx2 v[28:29], v1, s[8:11], s54 offen
    v_readlane_b32 s54, v32, 7
    v_readlane_b32 s55, v33, 7
    s_nop 4
    s_and_b32 s67, s55, 0xffff0000
    s_and_b32 s75, s55, 7
    buffer_load_dwordx2 v[30:31], v1, s[8:11], s54 offen
    s_mov_b32 s56, 8
    s_mov_b32 s57, s68
    s_lshl_b32 s53, s57, 10
    v_add_u32 v76, s53, v3
    ds_read_b128 v[8:11], v76 offset:8192
    v_mov_b32 v12, 0
    v_mov_b32 v13, 0
    v_mov_b32 v14, 0
    v_mov_b32 v15, 0
    s_waitcnt lgkmcnt(0)
L_group:
    s_cmp_lt_u32 s56, 64
    s_cbranch_scc1 L_nofill
    s_add_u32 s52, s52, 64
    s_lshl_b32 s53, s52, 3
    v_add_u32 v76, s53, v1
    ds_read_b64 v[32:33], v76 offset:20480
    s_mov_b32 s56, 0
    s_waitcnt lgkmcnt(0)
L_nofill:
    s_cmp_ge_u32 s50, s51
    s_cbranch_scc1 L_edges_flush
    s_waitcnt vmcnt(7)
    s_cmp_lg_u32 s68, s57
    s_cbranch_scc1 L_flush0
L_back0:
    v_lshlrev_b32 v34, 16, v16
    v_and_b32 v35, 0xffff0000, v16
    v_lshlrev_b32 v36, 16, v17
    v_and_b32 v37, 0xffff0000, v17
    v_readlane_b32 s54, v32, s56
    v_readlane_b32 s55, v33, s56
    v_fma_f32 v38, s60, v4, v8
    v_fma_f32 v39, s60, v5, v9
    v_fma_f32 v40, s60, v6, v10
    v_fma_f32 v41, s60, v7, v11
    v_add_f32 v34, v34, v38
    v_add_f32 v35, v35, v39
    v_add_f32 v36, v36, v40
    v_add_f32 v37, v37, v41
    s_and_b32 s60, s55, 0xffff0000
    s_and_b32 s68, s55, 7
    buffer_load_dwordx2 v[16:17], v1, s[8:11], s54 offen
    v_exp_f32 v42, v34
    v_exp_f32 v43, v35
    v_exp_f32 v44, v36
    v_exp_f32 v45, v37
    v_add_f32 v42, 1.0, v42
    v_add_f32 v43, 1.0, v43
    v_add_f32 v44, 1.0, v44
    v_add_f32 v45, 1.0, v45
    v_rcp_f32 v42, v42
    v_rcp_f32 v43, v43
    v_rcp_f32 v44, v44
    v_rcp_f32 v45, v45
    s_add_u32 s56, s56, 1
    s_add_u32 s50, s50, 1
    v_fma_f32 v12, v34, v42, v12
    v_fma_f32 v13, v35, v43, v13
    v_fma_f32 v14, v36, v44, v14
    v_fma_f32 v15, v37, v45, v15
    s_cmp_ge_u32 s50, s51
    s_cbranch_scc1 L_edges_flush
    s_waitcnt vmcnt(7)
    s_cmp_lg_u32 s69, s57
    s_cbranch_scc1 L_flush1
L_back1:
    v_lshlrev_b32 v34, 16, v18
    v_and_b32 v35, 0xffff0000, v18
    v_lshlrev_b32 v36, 16, v19
    v_and_b32 v37, 0xffff0000, v19
    v_readlane_b32 s54, v32, s56
    v_readlane_b32 s55, v33, s56
    v_fma_f32 v38, s61, v4, v8
    v_fma_f32 v39, s61, v5, v9
    v_fma_f32 v40, s61, v6, v10
    v_fma_f32 v41, s61, v7, v11
    v_add_f32 v34, v34, v38
    v_add_f32 v35, v35, v39
    v_add_f32 v36, v36, v40
    v_add_f32 v37, v37, v41
    s_and_b32 s61, s55, 0xffff0000
    s_and_b32 s69, s55, 7
    buffer_load_dwordx2 v[18:19], v1, s[8:11], s54 offen
    v_exp_f32 v42, v34
    v_exp_f32 v43, v35
    v_exp_f32 v44, v36
    v_exp_f32 v45, v37
    v_add_f32 v42, 1.0, v42
    v_add_f32 v43, 1.0, v43
    v_add_f32 v44, 1.0, v44
    v_add_f32 v45, 1.0, v45
    v_rcp_f32 v42, v42
    v_rcp_f32 v43, v43
    v_rcp_f32 v44, v44
    v_rcp_f32 v45, v45
    s_add_u32 s56, s56, 1
    s_add_u32 s50, s50, 1
    v_fma_f32 v12, v34, v42, v12
    v_fma_f32 v13, v35, v43, v13
    v_fma_f32 v14, v36, v44, v14
    v_fma_f32 v15, v37, v45, v15
    s_cmp_ge_u32 s50, s51
    s_cbranch_scc1 L_edges_flush
    s_waitcnt vmcnt(7)
    s_cmp_lg_u32 s70, s57
    s_cbranch_scc1 L_flush2
L_back2:
    v_lshlrev_b32 v34, 16, v20
    v_and_b32 v35, 0xffff0000, v20
    v_lshlrev_b32 v36, 16, v21
    v_and_b32 v37, 0xffff0000, v21
    v_readlane_b32 s54, v32, s56
    v_readlane_b32 s55, v33, s56
    v_fma_f32 v38, s62, v4, v8
    v_fma_f32 v39, s62, v5, v9
    v_fma_f32 v40, s62, v6, v10
    v_fma_f32 v41, s62, v7, v11
    v_add_f32 v34, v34, v38
    v_add_f32 v35, v35, v39
    v_add_f32 v36, v36, v40
    v_add_f32 v37, v37, v41
    s_and_b32 s62, s55, 0xffff0000
    s_and_b32 s70, s55, 7
    buffer_load_dwordx2 v[20:21], v1, s[8:11], s54 offen
    v_exp_f32 v42, v34
    v_exp_f32 v43, v35
    v_exp_f32 v44, v36
    v_exp_f32 v45, v37
    v_add_f32 v42, 1.0, v42
    v_add_f32 v43, 1.0, v43
    v_add_f32 v44, 1.0, v44
    v_add_f32 v45, 1.0, v45
    v_rcp_f32 v42, v42
    v_rcp_f32 v43, v43
    v_rcp_f32 v44, v44
    v_rcp_f32 v45, v45
    s_add_u32 s56, s56, 1
    s_add_u32 s50, s50, 1
    v_fma_f32 v12, v34, v42, v12
    v_fma_f32 v13, v35, v43, v13
    v_fma_f32 v14, v36, v44, v14
    v_fma_f32 v15, v37, v45, v15
    s_cmp_ge_u32 s50, s51
    s_cbranch_scc1 L_edges_flush
    s_waitcnt vmcnt(7)
    s_cmp_lg_u32 s71, s57
    s_cbranch_scc1 L_flush3
L_back3:
    v_lshlrev_b32 v34, 16, v22
    v_and_b32 v35, 0xffff0000, v22
    v_lshlrev_b32 v36, 16, v23
    v_and_b32 v37, 0xffff0000, v23
    v_readlane_b32 s54, v32, s56
    v_readlane_b32 s55, v33, s56
    v_fma_f32 v38, s63, v4, v8
    v_fma_f32 v39, s63, v5, v9
    v_fma_f32 v40, s63, v6, v10
    v_fma_f32 v41, s63, v7, v11
    v_add_f32 v34, v34, v38
    v_add_f32 v35, v35, v39
    v_add_f32 v36, v36, v40
    v_add_f32 v37, v37, v41
    s_and_b32 s63, s55, 0xffff0000
    s_and_b32 s71, s55, 7
    buffer_load_dwordx2 v[22:23], v1, s[8:11], s54 offen
    v_exp_f32 v42, v34
    v_exp_f32 v43, v35
    v_exp_f32 v44, v36
    v_exp_f32 v45, v37
    v_add_f32 v42, 1.0, v42
    v_add_f32 v43, 1.0, v43
    v_add_f32 v44, 1.0, v44
    v_add_f32 v45, 1.0, v45
    v_rcp_f32 v42, v42
    v_rcp_f32 v43, v43
    v_rcp_f32 v44, v44
    v_rcp_f32 v45, v45
    s_add_u32 s56, s56, 1
    s_add_u32 s50, s50, 1
    v_fma_f32 v12, v34, v42, v12
    v_fma_f32 v13, v35, v43, v13
    v_fma_f32 v14, v36, v44, v14
    v_fma_f32 v15, v37, v45, v15
    s_cmp_ge_u32 s50, s51
    s_cbranch_scc1 L_edges_flush
    s_waitcnt vmcnt(7)
    s_cmp_lg_u32 s72, s57
    s_cbranch_scc1 L_flush4
L_back4:
    v_lshlrev_b32 v34, 16, v24
    v_and_b32 v35, 0xffff0000, v24
    v_lshlrev_b32 v36, 16, v25
    v_and_b32 v37, 0xffff0000, v25
    v_readlane_b32 s54, v32, s56
    v_readlane_b32 s55, v33, s56
    v_fma_f32 v38, s64, v4, v8
    v_fma_f32 v39, s64, v5, v9
    v_fma_f32 v40, s64, v6, v10
    v_fma_f32 v41, s64, v7, v11
    v_add_f32 v34, v34, v38
    v_add_f32 v35, v35, v39
    v_add_f32 v36, v36, v40
    v_add_f32 v37, v37, v41
    s_and_b32 s64, s55, 0xffff0000
    s_and_b32 s72, s55, 7
    buffer_load_dwordx2 v[24:25], v1, s[8:11], s54 offen
    v_exp_f32 v42, v34
    v_exp_f32 v43, v35
    v_exp_f32 v44, v36
    v_exp_f32 v45, v37
    v_add_f32 v42, 1.0, v42
    v_add_f32 v43, 1.0, v43
    v_add_f32 v44, 1.0, v44
    v_add_f32 v45, 1.0, v45
    v_rcp_f32 v42, v42
    v_rcp_f32 v43, v43
    v_rcp_f32 v44, v44
    v_rcp_f32 v45, v45
    s_add_u32 s56, s56, 1
    s_add_u32 s50, s50, 1
    v_fma_f32 v12, v34, v42, v12
    v_fma_f32 v13, v35, v43, v13
    v_fma_f32 v14, v36, v44, v14
    v_fma_f32 v15, v37, v45, v15
    s_cmp_ge_u32 s50, s51
    s_cbranch_scc1 L_edges_flush
    s_waitcnt vmcnt(7)
    s_cmp_lg_u32 s73, s57
    s_cbranch_scc1 L_flush5
L_back5:
    v_lshlrev_b32 v34, 16, v26
    v_and_b32 v35, 0xffff0000, v26
    v_lshlrev_b32 v36, 16, v27
    v_and_b32 v37, 0xffff0000, v27
    v_readlane_b32 s54, v32, s56
    v_readlane_b32 s55, v33, s56
    v_fma_f32 v38, s65, v4, v8
    v_fma_f32 v39, s65, v5, v9
    v_fma_f32 v40, s65, v6, v10
    v_fma_f32 v41, s65, v7, v11
    v_add_f32 v34, v34, v38
    v_add_f32 v35, v35, v39
    v_add_f32 v36, v36, v40
    v_add_f32 v37, v37, v41
    s_and_b32 s65, s55, 0xffff0000
    s_and_b32 s73, s55, 7
    buffer_load_dwordx2 v[26:27], v1, s[8:11], s54 offen
    v_exp_f32 v42, v34
    v_exp_f32 v43, v35
    v_exp_f32 v44, v36
    v_exp_f32 v45, v37
    v_add_f32 v42, 1.0, v42
    v_add_f32 v43, 1.0, v43
    v_add_f32 v44, 1.0, v44
    v_add_f32 v45, 1.0, v45
    v_rcp_f32 v42, v42
    v_rcp_f32 v43, v43
    v_rcp_f32 v44, v44
    v_rcp_f32 v45, v45
    s_add_u32 s56, s56, 1
    s_add_u32 s50, s50, 1
    v_fma_f32 v12, v34, v42, v12
    v_fma_f32 v13, v35, v43, v13
    v_fma_f32 v14, v36, v44, v14
    v_fma_f32 v15, v37, v45, v15
    s_cmp_ge_u32 s50, s51
    s_cbranch_scc1 L_edges_flush
    s_waitcnt vmcnt(7)
    s_cmp_lg_u32 s74, s57
    s_cbranch_scc1 L_flush6
L_back6:
    v_lshlrev_b32 v34, 16, v28
    v_and_b32 v35, 0xffff0000, v28
    v_lshlrev_b32 v36, 16, v29
    v_and_b32 v37, 0xffff0000, v29
    v_readlane_b32 s54, v32, s56
    v_readlane_b32 s55, v33, s56
    v_fma_f32 v38, s66, v4, v8
    v_fma_f32 v39, s66, v5, v9
    v_fma_f32 v40, s66, v6, v10
    v_fma_f32 v41, s66, v7, v11
    v_add_f32 v34, v34, v38
    v_add_f32 v35, v35, v39
    v_add_f32 v36, v36, v40
    v_add_f32 v37, v37, v41
    s_and_b32 s66, s55, 0xffff0000
    s_and_b32 s74, s55, 7
    buffer_load_dwordx2 v[28:29], v1, s[8:11], s54 offen
    v_exp_f32 v42, v34
    v_exp_f32 v43, v35
    v_exp_f32 v44, v36
    v_exp_f32 v45, v37
    v_add_f32 v42, 1.0, v42
    v_add_f32 v43, 1.0, v43
    v_add_f32 v44, 1.0, v44
    v_add_f32 v45, 1.0, v45
    v_rcp_f32 v42, v42
    v_rcp_f32 v43, v43
    v_rcp_f32 v44, v44
    v_rcp_f32 v45, v45
    s_add_u32 s56, s56, 1
    s_add_u32 s50, s50, 1
    v_fma_f32 v12, v34, v42, v12
    v_fma_f32 v13, v35, v43, v13
    v_fma_f32 v14, v36, v44, v14
    v_fma_f32 v15, v37, v45, v15
    s_cmp_ge_u32 s50, s51
    s_cbranch_scc1 L_edges_flush
    s_waitcnt vmcnt(7)
    s_cmp_lg_u32 s75, s57
    s_cbranch_scc1 L_flush7
L_back7:
    v_lshlrev_b32 v34, 16, v30
    v_and_b32 v35, 0xffff0000, v30
    v_lshlrev_b32 v36, 16, v31
    v_and_b32 v37, 0xffff0000, v31
    v_readlane_b32 s54, v32, s56
    v_readlane_b32 s55, v33, s56
    v_fma_f32 v38, s67, v4, v8
    v_fma_f32 v39, s67, v5, v9
    v_fma_f32 v40, s67, v6, v10
    v_fma_f32 v41, s67, v7, v11
    v_add_f32 v34, v34, v38
    v_add_f32 v35, v35, v39
    v_add_f32 v36, v36, v40
    v_add_f32 v37, v37, v41
    s_and_b32 s67, s55, 0xffff0000
    s_and_b32 s75, s55, 7
    buffer_load_dwordx2 v[30:31], v1, s[8:11], s54 offen
    v_exp_f32 v42, v34
    v_exp_f32 v43, v35
    v_exp_f32 v44, v36
    v_exp_f32 v45, v37
    v_add_f32 v42, 1.0, v42
    v_add_f32 v43, 1.0, v43
    v_add_f32 v44, 1.0, v44
    v_add_f32 v45, 1.0, v45
    v_rcp_f32 v42, v42
    v_rcp_f32 v43, v43
    v_rcp_f32 v44, v44
    v_rcp_f32 v45, v45
    s_add_u32 s56, s56, 1
    s_add_u32 s50, s50, 1
    v_fma_f32 v12, v34, v42, v12
    v_fma_f32 v13, v35, v43, v13
    v_fma_f32 v14, v36, v44, v14
    v_fma_f32 v15, v37, v45, v15
    s_branch L_group
L_flush0:
    s_lshl_b32 s53, s57, 10
    v_add_u32 v76, s53, v3
    ds_read_b128 v[92:95], v76 offset:0
    s_waitcnt lgkmcnt(0)
    v_add_f32 v92, v92, v12
    v_add_f32 v93, v93, v13
    v_add_f32 v94, v94, v14
    v_add_f32 v95, v95, v15
    ds_write_b128 v76, v[92:95] offset:0
    v_mov_b32 v12, 0
    v_mov_b32 v13, 0
    v_mov_b32 v14, 0
    v_mov_b32 v15, 0
    s_mov_b32 s57, s68
    s_lshl_b32 s53, s57, 10
    v_add_u32 v76, s53, v3
    ds_read_b128 v[8:11], v76 offset:8192
    s_waitcnt lgkmcnt(0)
    s_branch L_back0
L_flush1:
    s_lshl_b32 s53, s57, 10
    v_add_u32 v76, s53, v3
    ds_read_b128 v[92:95], v76 offset:0
    s_waitcnt lgkmcnt(0)
    v_add_f32 v92, v92, v12
    v_add_f32 v93, v93, v13
    v_add_f32 v94, v94, v14
    v_add_f32 v95, v95, v15
    ds_write_b128 v76, v[92:95] offset:0
    v_mov_b32 v12, 0
    v_mov_b32 v13, 0
    v_mov_b32 v14, 0
    v_mov_b32 v15, 0
    s_mov_b32 s57, s69
    s_lshl_b32 s53, s57, 10
    v_add_u32 v76, s53, v3
    ds_read_b128 v[8:11], v76 offset:8192
    s_waitcnt lgkmcnt(0)
    s_branch L_back1
L_flush2:
    s_lshl_b32 s53, s57, 10
    v_add_u32 v76, s53, v3
    ds_read_b128 v[92:95], v76 offset:0
    s_waitcnt lgkmcnt(0)
    v_add_f32 v92, v92, v12
    v_add_f32 v93, v93, v13
    v_add_f32 v94, v94, v14
    v_add_f32 v95, v95, v15
    ds_write_b128 v76, v[92:95] offset:0
    v_mov_b32 v12, 0
    v_mov_b32 v13, 0
    v_mov_b32 v14, 0
    v_mov_b32 v15, 0
    s_mov_b32 s57, s70
    s_lshl_b32 s53, s57, 10
    v_add_u32 v76, s53, v3
    ds_read_b128 v[8:11], v76 offset:8192
    s_waitcnt lgkmcnt(0)
    s_branch L_back2
L_flush3:
    s_lshl_b32 s53, s57, 10
    v_add_u32 v76, s53, v3
    ds_read_b128 v[92:95], v76 offset:0
    s_waitcnt lgkmcnt(0)
    v_add_f32 v92, v92, v12
    v_add_f32 v93, v93, v13
    v_add_f32 v94, v94, v14
    v_add_f32 v95, v95, v15
    ds_write_b128 v76, v[92:95] offset:0
    v_mov_b32 v12, 0
    v_mov_b32 v13, 0
    v_mov_b32 v14, 0
    v_mov_b32 v15, 0
    s_mov_b32 s57, s71
    s_lshl_b32 s53, s57, 10
    v_add_u32 v76, s53, v3
    ds_read_b128 v[8:11], v76 offset:8192
    s_waitcnt lgkmcnt(0)
    s_branch L_back3
L_flush4:
    s_lshl_b32 s53, s57, 10
    v_add_u32 v76, s53, v3
    ds_read_b128 v[92:95], v76 offset:0
    s_waitcnt lgkmcnt(0)
    v_add_f32 v92, v92, v12
    v_add_f32 v93, v93, v13
    v_add_f32 v94, v94, v14
    v_add_f32 v95, v95, v15
    ds_write_b128 v76, v[92:95] offset:0
    v_mov_b32 v12, 0
    v_mov_b32 v13, 0
    v_mov_b32 v14, 0
    v_mov_b32 v15, 0
    s_mov_b32 s57, s72
    s_lshl_b32 s53, s57, 10
    v_add_u32 v76, s53, v3
    ds_read_b128 v[8:11], v76 offset:8192
    s_waitcnt lgkmcnt(0)
    s_branch L_back4
L_flush5:
    s_lshl_b32 s53, s57, 10
    v_add_u32 v76, s53, v3
    ds_read_b128 v[92:95], v76 offset:0
    s_waitcnt lgkmcnt(0)
    v_add_f32 v92, v92, v12
    v_add_f32 v93, v93, v13
    v_add_f32 v94, v94, v14
    v_add_f32 v95, v95, v15
    ds_write_b128 v76, v[92:95] offset:0
    v_mov_b32 v12, 0
    v_mov_b32 v13, 0
    v_mov_b32 v14, 0
    v_mov_b32 v15, 0
    s_mov_b32 s57, s73
    s_lshl_b32 s53, s57, 10
    v_add_u32 v76, s53, v3
    ds_read_b128 v[8:11], v76 offset:8192
    s_waitcnt lgkmcnt(0)
    s_branch L_back5
L_flush6:
    s_lshl_b32 s53, s57, 10
    v_add_u32 v76, s53, v3
    ds_read_b128 v[92:95], v76 offset:0
    s_waitcnt lgkmcnt(0)
    v_add_f32 v92, v92, v12
    v_add_f32 v93, v93, v13
    v_add_f32 v94, v94, v14
    v_add_f32 v95, v95, v15
    ds_write_b128 v76, v[92:95] offset:0
    v_mov_b32 v12, 0
    v_mov_b32 v13, 0
    v_mov_b32 v14, 0
    v_mov_b32 v15, 0
    s_mov_b32 s57, s74
    s_lshl_b32 s53, s57, 10
    v_add_u32 v76, s53, v3
    ds_read_b128 v[8:11], v76 offset:8192
    s_waitcnt lgkmcnt(0)
    s_branch L_back6
L_flush7:
    s_lshl_b32 s53, s57, 10
    v_add_u32 v76, s53, v3
    ds_read_b128 v[92:95], v76 offset:0
    s_waitcnt lgkmcnt(0)
    v_add_f32 v92, v92, v12
    v_add_f32 v93, v93, v13
    v_add_f32 v94, v94, v14
    v_add_f32 v95, v95, v15
    ds_write_b128 v76, v[92:95] offset:0
    v_mov_b32 v12, 0
    v_mov_b32 v13, 0
    v_mov_b32 v14, 0
    v_mov_b32 v15, 0
    s_mov_b32 s57, s75
    s_lshl_b32 s53, s57, 10
    v_add_u32 v76, s53, v3
    ds_read_b128 v[8:11], v76 offset:8192
    s_waitcnt lgkmcnt(0)
    s_branch L_back7
L_edges_flush:
    s_lshl_b32 s53, s57, 10
    v_add_u32 v76, s53, v3
    ds_read_b128 v[92:95], v76 offset:0
    s_waitcnt lgkmcnt(0)
    v_add_f32 v92, v92, v12
    v_add_f32 v93, v93, v13
    v_add_f32 v94, v94, v14
    v_add_f32 v95, v95, v15
    ds_write_b128 v76, v[92:95] offset:0
L_edges_done:
    s_waitcnt vmcnt(0) lgkmcnt(0)
    s_barrier
    s_add_u32 s47, s47, 512
    s_branch L_batch
L_final:
    v_cmp_gt_u32 vcc, 128, v0
    s_and_saveexec_b64 s[76:77], vcc
    v_lshlrev_b32 v46, 6, v0
    ds_read_b128 v[48:51], v46 offset:0
    ds_read_b128 v[52:55], v46 offset:16
    ds_read_b128 v[56:59], v46 offset:32
    ds_read_b128 v[60:63], v46 offset:48
    s_mov_b32 s48, 3207688728
    s_waitcnt lgkmcnt(0)
    v_mul_f32 v48, s48, v48
    v_mul_f32 v49, s48, v49
    v_mul_f32 v50, s48, v50
    v_mul_f32 v51, s48, v51
    v_mul_f32 v52, s48, v52
    v_mul_f32 v53, s48, v53
    v_mul_f32 v54, s48, v54
    v_mul_f32 v55, s48, v55
    v_mul_f32 v56, s48, v56
    v_mul_f32 v57, s48, v57
    v_mul_f32 v58, s48, v58
    v_mul_f32 v59, s48, v59
    v_mul_f32 v60, s48, v60
    v_mul_f32 v61, s48, v61
    v_mul_f32 v62, s48, v62
    v_mul_f32 v63, s48, v63
    v_cvt_pk_bf16_f32 v64, v48, v49
    v_cvt_pk_bf16_f32 v65, v50, v51
    v_cvt_pk_bf16_f32 v66, v52, v53
    v_cvt_pk_bf16_f32 v67, v54, v55
    v_cvt_pk_bf16_f32 v68, v56, v57
    v_cvt_pk_bf16_f32 v69, v58, v59
    v_cvt_pk_bf16_f32 v70, v60, v61
    v_cvt_pk_bf16_f32 v71, v62, v63
    v_lshlrev_b32 v47, 5, v0
    ds_write_b128 v47, v[64:67] offset:16384
    ds_write_b128 v47, v[68:71] offset:16400
    v_mov_b32 v72, 0
    v_mov_b32 v73, 0
    v_mov_b32 v74, 0
    v_mov_b32 v75, 0
    ds_write_b128 v47, v[72:75] offset:20480
    ds_write_b128 v47, v[72:75] offset:20496
    s_mov_b64 exec, s[76:77]
    s_waitcnt lgkmcnt(0)
    s_barrier
    v_and_b32 v46, 15, v2
    v_lshrrev_b32 v47, 4, v2
    v_lshlrev_b32 v48, 9, v46
    v_lshl_add_u32 v48, v47, 4, v48
    ds_read_b128 v[64:67], v48 offset:16384
    ds_read_b128 v[68:71], v48 offset:16448
    ds_read_b128 v[72:75], v48 offset:16512
    ds_read_b128 v[76:79], v48 offset:16576
    ds_read_b128 v[80:83], v48 offset:16640
    ds_read_b128 v[84:87], v48 offset:16704
    ds_read_b128 v[88:91], v48 offset:16768
    ds_read_b128 v[92:95], v48 offset:16832
    s_lshl_b32 s78, s3, 14
    s_lshl_b32 s49, s3, 6
    v_lshlrev_b32 v49, 1, v46
    buffer_load_ushort v52, v49, s[36:39], s49 offen offset:0
    buffer_load_ushort v53, v49, s[36:39], s49 offen offset:32
    v_lshlrev_b32 v50, 4, v47
    ds_read_b128 v[56:59], v50 offset:25728
    v_mov_b32 v16, 0
    v_mov_b32 v17, 0
    v_mov_b32 v18, 0
    v_mov_b32 v19, 0
    v_mov_b32 v20, 0
    v_mov_b32 v21, 0
    v_mov_b32 v22, 0
    v_mov_b32 v23, 0
    s_waitcnt vmcnt(0) lgkmcnt(0)
    buffer_load_dwordx4 v[96:99], v48, s[24:27], s78 offen offset:0
    buffer_load_dwordx4 v[100:103], v48, s[24:27], s78 offen offset:64
    buffer_load_dwordx4 v[104:107], v48, s[24:27], s78 offen offset:128
    buffer_load_dwordx4 v[108:111], v48, s[24:27], s78 offen offset:192
    buffer_load_dwordx4 v[112:115], v48, s[24:27], s78 offen offset:256
    buffer_load_dwordx4 v[116:119], v48, s[24:27], s78 offen offset:320
    buffer_load_dwordx4 v[120:123], v48, s[24:27], s78 offen offset:384
    buffer_load_dwordx4 v[124:127], v48, s[24:27], s78 offen offset:448
    s_add_u32 s78, s78, 8192
    s_waitcnt vmcnt(0)
    v_mfma_f32_16x16x32_bf16 v[16:19], v[64:67], v[96:99], v[16:19]
    v_mfma_f32_16x16x32_bf16 v[16:19], v[68:71], v[100:103], v[16:19]
    v_mfma_f32_16x16x32_bf16 v[16:19], v[72:75], v[104:107], v[16:19]
    v_mfma_f32_16x16x32_bf16 v[16:19], v[76:79], v[108:111], v[16:19]
    v_mfma_f32_16x16x32_bf16 v[16:19], v[80:83], v[112:115], v[16:19]
    v_mfma_f32_16x16x32_bf16 v[16:19], v[84:87], v[116:119], v[16:19]
    v_mfma_f32_16x16x32_bf16 v[16:19], v[88:91], v[120:123], v[16:19]
    v_mfma_f32_16x16x32_bf16 v[16:19], v[92:95], v[124:127], v[16:19]
    s_nop 7
    buffer_load_dwordx4 v[96:99], v48, s[24:27], s78 offen offset:0
    buffer_load_dwordx4 v[100:103], v48, s[24:27], s78 offen offset:64
    buffer_load_dwordx4 v[104:107], v48, s[24:27], s78 offen offset:128
    buffer_load_dwordx4 v[108:111], v48, s[24:27], s78 offen offset:192
    buffer_load_dwordx4 v[112:115], v48, s[24:27], s78 offen offset:256
    buffer_load_dwordx4 v[116:119], v48, s[24:27], s78 offen offset:320
    buffer_load_dwordx4 v[120:123], v48, s[24:27], s78 offen offset:384
    buffer_load_dwordx4 v[124:127], v48, s[24:27], s78 offen offset:448
    s_add_u32 s78, s78, 8192
    s_waitcnt vmcnt(0)
    v_mfma_f32_16x16x32_bf16 v[20:23], v[64:67], v[96:99], v[20:23]
    v_mfma_f32_16x16x32_bf16 v[20:23], v[68:71], v[100:103], v[20:23]
    v_mfma_f32_16x16x32_bf16 v[20:23], v[72:75], v[104:107], v[20:23]
    v_mfma_f32_16x16x32_bf16 v[20:23], v[76:79], v[108:111], v[20:23]
    v_mfma_f32_16x16x32_bf16 v[20:23], v[80:83], v[112:115], v[20:23]
    v_mfma_f32_16x16x32_bf16 v[20:23], v[84:87], v[116:119], v[20:23]
    v_mfma_f32_16x16x32_bf16 v[20:23], v[88:91], v[120:123], v[20:23]
    v_mfma_f32_16x16x32_bf16 v[20:23], v[92:95], v[124:127], v[20:23]
    s_nop 7
    s_nop 15
    v_cvt_f32_u32 v56, v56
    v_cvt_f32_u32 v57, v57
    v_cvt_f32_u32 v58, v58
    v_cvt_f32_u32 v59, v59
    s_lshl_b32 s48, s2, 11
    s_lshl_b32 s49, s3, 6
    s_add_u32 s48, s48, s49
    v_lshlrev_b32 v50, 10, v47
    v_lshl_add_u32 v50, v46, 1, v50
    v_cmp_gt_u32 vcc, 32, v2
    s_and_saveexec_b64 s[44:45], vcc
    v_lshlrev_b32 v52, 16, v52
    v_fma_f32 v16, v56, v52, v16
    v_cvt_pk_bf16_f32 v60, v16, v16
    buffer_store_short v60, v50, s[28:31], s48 offen offset:0
    v_fma_f32 v17, v57, v52, v17
    v_cvt_pk_bf16_f32 v60, v17, v17
    buffer_store_short v60, v50, s[28:31], s48 offen offset:256
    v_fma_f32 v18, v58, v52, v18
    v_cvt_pk_bf16_f32 v60, v18, v18
    buffer_store_short v60, v50, s[28:31], s48 offen offset:512
    v_fma_f32 v19, v59, v52, v19
    v_cvt_pk_bf16_f32 v60, v19, v19
    buffer_store_short v60, v50, s[28:31], s48 offen offset:768
    v_lshlrev_b32 v53, 16, v53
    v_fma_f32 v20, v56, v53, v20
    v_cvt_pk_bf16_f32 v60, v20, v20
    buffer_store_short v60, v50, s[28:31], s48 offen offset:32
    v_fma_f32 v21, v57, v53, v21
    v_cvt_pk_bf16_f32 v60, v21, v21
    buffer_store_short v60, v50, s[28:31], s48 offen offset:288
    v_fma_f32 v22, v58, v53, v22
    v_cvt_pk_bf16_f32 v60, v22, v22
    buffer_store_short v60, v50, s[28:31], s48 offen offset:544
    v_fma_f32 v23, v59, v53, v23
    v_cvt_pk_bf16_f32 v60, v23, v23
    buffer_store_short v60, v50, s[28:31], s48 offen offset:800
L_main_end:
    s_endpgm
.section .rodata,"a"
.p2align 6
.amdhsa_kernel prep_kernel
  .amdhsa_next_free_vgpr 128
  .amdhsa_next_free_sgpr 102
  .amdhsa_accum_offset 128
  .amdhsa_group_segment_fixed_size 0
  .amdhsa_kernarg_size 88
  .amdhsa_user_sgpr_count 2
  .amdhsa_user_sgpr_kernarg_segment_ptr 1
  .amdhsa_system_sgpr_workgroup_id_x 1
.end_amdhsa_kernel
.section .rodata,"a"
.p2align 6
.amdhsa_kernel main_kernel
  .amdhsa_next_free_vgpr 128
  .amdhsa_next_free_sgpr 102
  .amdhsa_accum_offset 128
  .amdhsa_group_segment_fixed_size 0
  .amdhsa_kernarg_size 88
  .amdhsa_user_sgpr_count 2
  .amdhsa_user_sgpr_kernarg_segment_ptr 1
  .amdhsa_system_sgpr_workgroup_id_x 1
.end_amdhsa_kernel
```
